```python
import torch

def _softmax(x, axis=-1):
    return torch.softmax(x, dim=axis)
def _gelu(x):
    return torch.nn.functional.gelu(x, approximate="tanh")
def _silu(x):
    return torch.nn.functional.silu(x)
def _sigmoid(x):
    return torch.sigmoid(x)
def _layernorm(x, axis=-1, eps=1e-5):
    m = x.mean(dim=axis, keepdim=True)
    v = x.var(dim=axis, keepdim=True, unbiased=False)
    return (x - m) / torch.sqrt(v + eps)
def _scatter_add(tgt, idx, src, axis=0):
    return tgt.clone().index_add_(axis, idx, src)
def _segment_sum(src, seg, n):
    out = torch.zeros((n,) + src.shape[1:], dtype=src.dtype)
    return out.index_add_(0, seg, src)
def _pad(x, pw):
    flat = tuple(v for pair in reversed(pw) for v in pair)
    return torch.nn.functional.pad(x, flat)

kernel_name = 'standalone__softmax_full_bidir__decode'

def setup_inputs():

    _w = (lambda a: (lambda t: t.to(torch.bfloat16) if t.is_floating_point() else t)(torch.as_tensor(a)))
    B, H, Sq, Skv, Dh = 1, 32, 1, 65536, 128
    return {
        "q": _w((lambda *s: torch.randn(*s, dtype=torch.bfloat16) * 0.8)(B, H, Sq, Dh)),
        "k": _w((lambda *s: torch.randn(*s, dtype=torch.bfloat16) * 0.8)(B, H, Skv, Dh)),
        "v": _w((lambda *s: torch.randn(*s, dtype=torch.bfloat16) * 0.05)(B, H, Skv, Dh)),
    }

def reference(q, k, v):
    scale = q.shape[-1] ** -0.5
    scores = torch.einsum('bhqd,bhkd->bhqk', q, k) * scale
    attn = _softmax(scores, axis=-1)
    return torch.einsum('bhqk,bhkd->bhqd', attn, v)
```

```asm
; @launch grid=(256,1,1) block=(64,1,1) lds=0
.amdgcn_target "amdgcn-amd-amdhsa--gfx950"
.text
.globl standalone__softmax_full_bidir__decode_kernel
.p2align 8
.type standalone__softmax_full_bidir__decode_kernel,@function
standalone__softmax_full_bidir__decode_kernel:
    s_cmp_ge_u32 s2, 256
    s_cbranch_scc1 L_exit
    s_load_dwordx4 s[4:7], s[0:1], 0
    s_load_dwordx4 s[8:11], s[0:1], 16
    s_load_dwordx4 s[12:15], s[0:1], 32
    s_mov_b32 s47, s2
    s_bfe_u32 s2, s47, 0x20000
    s_lshl_b32 s2, s2, 0
    s_bfe_u32 s30, s47, 0x10002
    s_lshl_b32 s30, s30, 3
    s_or_b32 s2, s2, s30
    s_bfe_u32 s30, s47, 0x10003
    s_lshl_b32 s30, s30, 2
    s_or_b32 s2, s2, s30
    s_bfe_u32 s30, s47, 0x40004
    s_lshl_b32 s30, s30, 4
    s_or_b32 s2, s2, s30
    s_and_b32 s25, s2, 7
    s_lshr_b32 s24, s2, 3
    v_lshlrev_b32 v2, 4, v0
    v_bfe_u32 v48, v0, 2, 2
    v_lshlrev_b32 v1, 8, v48
    v_lshrrev_b32 v48, 4, v0
    v_lshlrev_b32 v48, 6, v48
    v_and_b32 v49, 3, v0
    v_lshl_add_u32 v48, v49, 4, v48
    v_add_u32 v1, v1, v48
    s_lshl_b32 s30, s24, 8
    v_add_u32 v48, s30, v48
    v_mov_b32 v3, 0
    s_mov_b32 s50, 0x204000
    s_bfe_u32 s31, s24, 0x10001
    s_mul_i32 s31, s31, 0x2000
    s_xor_b32 s50, s50, s31
    s_bfe_u32 s40, s25, 0x10000
    s_lshl_b32 s40, s40, 12
    s_bfe_u32 s31, s25, 0x20001
    s_lshl_b32 s31, s31, 14
    s_or_b32 s40, s40, s31
    s_xor_b32 s40, s40, s50
    s_mov_b32 s34, 0x204000
    s_lshl_b32 s30, s24, 24
    s_mov_b32 s18, 0x1000000
    s_mov_b32 s19, 0x20000
    s_mov_b32 s22, 0x1000000
    s_mov_b32 s23, 0x20000
    s_waitcnt lgkmcnt(0)
    s_add_u32 s16, s6, s30
    s_addc_u32 s17, s7, 0
    s_add_u32 s20, s8, s30
    s_addc_u32 s21, s9, 0
    global_load_dwordx4 v[28:31], v48, s[4:5]
    s_bitcmp1_b32 s34, 15
    s_cselect_b32 s41, 0x20a000, 0
    s_xor_b32 s41, s41, s40
    s_xor_b32 s41, s41, s34
    s_add_u32 s34, s34, 0x2000
    s_or_b32 s34, s34, 0x204000
    buffer_load_dwordx4 v[80:83], v1, s[16:19], s41 offen offset:0 nt
    buffer_load_dwordx4 v[84:87], v1, s[16:19], s41 offen offset:1024 nt
    buffer_load_dwordx4 v[88:91], v1, s[16:19], s41 offen offset:2048 nt
    buffer_load_dwordx4 v[92:95], v1, s[16:19], s41 offen offset:3072 nt
    s_bitcmp1_b32 s34, 15
    s_cselect_b32 s42, 0x20a000, 0
    s_xor_b32 s42, s42, s40
    s_xor_b32 s42, s42, s34
    s_add_u32 s34, s34, 0x2000
    s_or_b32 s34, s34, 0x204000
    buffer_load_dwordx4 v[96:99], v1, s[16:19], s42 offen offset:0 nt
    buffer_load_dwordx4 v[100:103], v1, s[16:19], s42 offen offset:1024 nt
    buffer_load_dwordx4 v[104:107], v1, s[16:19], s42 offen offset:2048 nt
    buffer_load_dwordx4 v[108:111], v1, s[16:19], s42 offen offset:3072 nt
    s_bitcmp1_b32 s34, 15
    s_cselect_b32 s43, 0x20a000, 0
    s_xor_b32 s43, s43, s40
    s_xor_b32 s43, s43, s34
    s_add_u32 s34, s34, 0x2000
    s_or_b32 s34, s34, 0x204000
    buffer_load_dwordx4 v[112:115], v1, s[16:19], s43 offen offset:0 nt
    buffer_load_dwordx4 v[116:119], v1, s[16:19], s43 offen offset:1024 nt
    buffer_load_dwordx4 v[120:123], v1, s[16:19], s43 offen offset:2048 nt
    buffer_load_dwordx4 v[124:127], v1, s[16:19], s43 offen offset:3072 nt
    buffer_load_dwordx4 a[0:3], v2, s[20:23], s41 offen offset:0 nt
    buffer_load_dwordx4 a[4:7], v2, s[20:23], s41 offen offset:1024 nt
    buffer_load_dwordx4 a[8:11], v2, s[20:23], s41 offen offset:2048 nt
    buffer_load_dwordx4 a[12:15], v2, s[20:23], s41 offen offset:3072 nt
    buffer_load_dwordx4 a[16:19], v2, s[20:23], s42 offen offset:0 nt
    buffer_load_dwordx4 a[20:23], v2, s[20:23], s42 offen offset:1024 nt
    buffer_load_dwordx4 a[24:27], v2, s[20:23], s42 offen offset:2048 nt
    buffer_load_dwordx4 a[28:31], v2, s[20:23], s42 offen offset:3072 nt
    buffer_load_dwordx4 a[32:35], v2, s[20:23], s43 offen offset:0 nt
    buffer_load_dwordx4 a[36:39], v2, s[20:23], s43 offen offset:1024 nt
    buffer_load_dwordx4 a[40:43], v2, s[20:23], s43 offen offset:2048 nt
    buffer_load_dwordx4 a[44:47], v2, s[20:23], s43 offen offset:3072 nt
    s_mul_i32 s30, s24, 1024
    s_add_u32 s30, s30, 0x100000
    s_add_u32 s36, s14, s30
    s_addc_u32 s37, s15, 0
    s_cmp_lg_u32 s2, 0
    s_cbranch_scc1 L_noinit
    v_mul_u32_u24 v49, 1024, v0
    v_mov_b32 v45, 0x40000
    s_mov_b32 exec_hi, 0
    global_load_dword v50, v45, s[14:15] sc0 sc1
    global_store_dword v49, v3, s[36:37] sc0 sc1
    s_waitcnt vmcnt(0)
    s_mov_b64 exec, 1
    v_add_u32 v50, 1, v50
    v_or_b32 v50, 0x80000000, v50
    global_store_dword v45, v50, s[14:15] sc0 sc1
    global_store_dword v3, v50, s[12:13] sc0 sc1
    s_mov_b64 exec, -1
L_noinit:
    v_and_b32 v48, 15, v0
    v_and_b32 v49, 1, v0
    v_lshlrev_b32 v49, 4, v49
    v_mov_b32 v54, 0xffff
    v_lshlrev_b32 v49, v49, v54
    v_lshrrev_b32 v46, 1, v48
    v_cmp_eq_u32 vcc, 0, v46
    s_nop 1
    v_cndmask_b32 v4, 0, v49, vcc
    v_cmp_eq_u32 vcc, 1, v46
    s_nop 1
    v_cndmask_b32 v5, 0, v49, vcc
    v_cmp_eq_u32 vcc, 2, v46
    s_nop 1
    v_cndmask_b32 v6, 0, v49, vcc
    v_cmp_eq_u32 vcc, 3, v46
    s_nop 1
    v_cndmask_b32 v7, 0, v49, vcc
    v_mov_b32 v44, 0
    v_mov_b32 v24, 0
    v_mov_b32 v25, 0
    v_mov_b32 v26, 0
    v_mov_b32 v27, 0
    v_mov_b32 v47, 0x3fb8aa3b
    s_mov_b32 s28, 0xff7fffff
    s_mov_b32 s38, 0xaaaaaaaa
    s_mov_b32 s39, 0xaaaaaaaa
    s_lshl_b32 s30, s2, 10
    v_add_u32 v51, s30, v2
    v_lshlrev_b32 v52, 4, v48
    v_bfe_u32 v49, v0, 4, 1
    v_lshl_add_u32 v52, v49, 3, v52
    v_lshrrev_b32 v49, 5, v0
    v_lshl_add_u32 v52, v49, 2, v52
    s_lshl_b32 s30, s24, 8
    v_add_u32 v52, s30, v52
    v_lshrrev_b32 v46, 2, v48
    s_waitcnt vmcnt(24)
    v_cmp_eq_u32 vcc, 0, v46
    s_nop 1
    v_cndmask_b32 v8, 0, v28, vcc
    v_cndmask_b32 v9, 0, v29, vcc
    v_cndmask_b32 v10, 0, v30, vcc
    v_cndmask_b32 v11, 0, v31, vcc
    v_cmp_eq_u32 vcc, 1, v46
    s_nop 1
    v_cndmask_b32 v12, 0, v28, vcc
    v_cndmask_b32 v13, 0, v29, vcc
    v_cndmask_b32 v14, 0, v30, vcc
    v_cndmask_b32 v15, 0, v31, vcc
    v_cmp_eq_u32 vcc, 2, v46
    s_nop 1
    v_cndmask_b32 v16, 0, v28, vcc
    v_cndmask_b32 v17, 0, v29, vcc
    v_cndmask_b32 v18, 0, v30, vcc
    v_cndmask_b32 v19, 0, v31, vcc
    v_cmp_eq_u32 vcc, 3, v46
    s_nop 1
    v_cndmask_b32 v20, 0, v28, vcc
    v_cndmask_b32 v21, 0, v29, vcc
    v_cndmask_b32 v22, 0, v30, vcc
    v_cndmask_b32 v23, 0, v31, vcc
    s_mov_b32 s27, 163
    s_and_b32 s30, s47, 7
    s_lshl_b32 s30, s30, 8
    s_add_u32 s30, s30, 0x80000
    s_add_u32 s48, s14, s30
    s_addc_u32 s49, s15, 0
    v_and_b32 v76, 31, v0
    v_lshlrev_b32 v76, 2, v76
    s_lshr_b32 s30, s47, 3
    s_lshl_b32 s30, s30, 2
    v_mov_b32 v77, s30
    s_lshl_b32 s44, s47, 20
    s_mov_b32 s45, 0
    s_mov_b32 s46, 0
    s_mov_b32 s35, 0
    v_mov_b32 v50, 0
    s_branch L_deep
.p2align 6
L_shallow:
    v_mov_b32 v78, s44
    s_mov_b64 exec, 1
    global_store_dword v77, v78, s[48:49]
    s_mov_b64 exec, -1
    global_load_dword v79, v76, s[48:49] sc1
    s_waitcnt vmcnt(20)
    v_mfma_f32_16x16x32_bf16 v[64:67], v[80:83], v[8:11], 0
    s_bitcmp1_b32 s34, 15
    s_cselect_b32 s41, 0x20a000, 0
    s_xor_b32 s41, s41, s40
    s_xor_b32 s41, s41, s34
    s_add_u32 s34, s34, 0x2000
    s_or_b32 s34, s34, 0x204000
    buffer_load_dwordx4 v[80:83], v1, s[16:19], s41 offen offset:0 nt
    s_waitcnt vmcnt(20)
    v_mfma_f32_16x16x32_bf16 v[64:67], v[84:87], v[12:15], v[64:67]
    buffer_load_dwordx4 v[84:87], v1, s[16:19], s41 offen offset:1024 nt
    s_waitcnt vmcnt(20)
    v_mfma_f32_16x16x32_bf16 v[64:67], v[88:91], v[16:19], v[64:67]
    buffer_load_dwordx4 v[88:91], v1, s[16:19], s41 offen offset:2048 nt
    s_waitcnt vmcnt(20)
    v_mfma_f32_16x16x32_bf16 v[64:67], v[92:95], v[20:23], v[64:67]
    buffer_load_dwordx4 v[92:95], v1, s[16:19], s41 offen offset:3072 nt
    s_waitcnt vmcnt(20)
    v_mfma_f32_16x16x32_bf16 v[68:71], v[96:99], v[8:11], 0
    s_bitcmp1_b32 s34, 15
    s_cselect_b32 s42, 0x20a000, 0
    s_xor_b32 s42, s42, s40
    s_xor_b32 s42, s42, s34
    s_add_u32 s34, s34, 0x2000
    s_or_b32 s34, s34, 0x204000
    buffer_load_dwordx4 v[96:99], v1, s[16:19], s42 offen offset:0 nt
    s_waitcnt vmcnt(20)
    v_mfma_f32_16x16x32_bf16 v[68:71], v[100:103], v[12:15], v[68:71]
    buffer_load_dwordx4 v[100:103], v1, s[16:19], s42 offen offset:1024 nt
    s_waitcnt vmcnt(20)
    v_mfma_f32_16x16x32_bf16 v[68:71], v[104:107], v[16:19], v[68:71]
    buffer_load_dwordx4 v[104:107], v1, s[16:19], s42 offen offset:2048 nt
    v_mov_b32_dpp v45, v64 quad_perm:[0,0,0,0] row_mask:0xf bank_mask:0xf
    v_mov_b32_dpp v46, v66 quad_perm:[2,2,2,2] row_mask:0xf bank_mask:0xf
    s_waitcnt vmcnt(20)
    v_mfma_f32_16x16x32_bf16 v[68:71], v[108:111], v[20:23], v[68:71]
    buffer_load_dwordx4 v[108:111], v1, s[16:19], s42 offen offset:3072 nt
    v_add_f32_dpp v45, v65, v45 quad_perm:[1,1,1,1] row_mask:0xf bank_mask:0xf
    v_add_f32_dpp v46, v67, v46 quad_perm:[3,3,3,3] row_mask:0xf bank_mask:0xf
    v_add_f32 v54, v45, v46
    v_cvt_pk_bf16_f32 v54, 0, v54
    v_mul_f32 v54, 0x3db504f3, v54
    v_cvt_pk_bf16_f32 v54, 0, v54
    v_mul_f32 v54, v47, v54
    s_waitcnt vmcnt(20)
    v_mfma_f32_16x16x32_bf16 v[72:75], v[112:115], v[8:11], 0
    s_bitcmp1_b32 s34, 15
    s_cselect_b32 s43, 0x20a000, 0
    s_xor_b32 s43, s43, s40
    s_xor_b32 s43, s43, s34
    s_add_u32 s34, s34, 0x2000
    s_or_b32 s34, s34, 0x204000
    buffer_load_dwordx4 v[112:115], v1, s[16:19], s43 offen offset:0 nt
    s_waitcnt vmcnt(20)
    v_mfma_f32_16x16x32_bf16 v[72:75], v[116:119], v[12:15], v[72:75]
    buffer_load_dwordx4 v[116:119], v1, s[16:19], s43 offen offset:1024 nt
    s_waitcnt vmcnt(20)
    v_mfma_f32_16x16x32_bf16 v[72:75], v[120:123], v[16:19], v[72:75]
    buffer_load_dwordx4 v[120:123], v1, s[16:19], s43 offen offset:2048 nt
    v_mov_b32_dpp v45, v68 quad_perm:[0,0,0,0] row_mask:0xf bank_mask:0xf
    v_mov_b32_dpp v46, v70 quad_perm:[2,2,2,2] row_mask:0xf bank_mask:0xf
    s_waitcnt vmcnt(20)
    v_mfma_f32_16x16x32_bf16 v[72:75], v[124:127], v[20:23], v[72:75]
    buffer_load_dwordx4 v[124:127], v1, s[16:19], s43 offen offset:3072 nt
    v_add_f32_dpp v45, v69, v45 quad_perm:[1,1,1,1] row_mask:0xf bank_mask:0xf
    v_add_f32_dpp v46, v71, v46 quad_perm:[3,3,3,3] row_mask:0xf bank_mask:0xf
    v_add_f32 v55, v45, v46
    v_cvt_pk_bf16_f32 v55, 0, v55
    v_mul_f32 v55, 0x3db504f3, v55
    v_cvt_pk_bf16_f32 v55, 0, v55
    v_mul_f32 v55, v47, v55
    v_mov_b32_dpp v45, v72 quad_perm:[0,0,0,0] row_mask:0xf bank_mask:0xf
    v_mov_b32_dpp v46, v74 quad_perm:[2,2,2,2] row_mask:0xf bank_mask:0xf
    s_nop 0
    v_add_f32_dpp v45, v73, v45 quad_perm:[1,1,1,1] row_mask:0xf bank_mask:0xf
    v_add_f32_dpp v46, v75, v46 quad_perm:[3,3,3,3] row_mask:0xf bank_mask:0xf
    v_add_f32 v56, v45, v46
    v_cvt_pk_bf16_f32 v56, 0, v56
    v_mul_f32 v56, 0x3db504f3, v56
    v_cvt_pk_bf16_f32 v56, 0, v56
    v_mul_f32 v56, v47, v56
    v_max3_f32 v53, v54, v55, v56
    v_cmp_lt_f32 vcc, s28, v53
    s_cbranch_vccnz L_raise_1
L_keep_1:
    v_subrev_f32 v54, s28, v54
    v_subrev_f32 v55, s28, v55
    v_subrev_f32 v56, s28, v56
    v_exp_f32 v54, v54
    v_exp_f32 v55, v55
    v_exp_f32 v56, v56
    v_cvt_pk_bf16_f32 v58, v54, v54
    v_cvt_pk_bf16_f32 v59, v55, v55
    v_cvt_pk_bf16_f32 v60, v56, v56
    v_add_f32 v44, v54, v44
    v_add_f32 v44, v55, v44
    v_add_f32 v44, v56, v44
    v_and_b32_dpp v28, v58, v4 row_newbcast:0 row_mask:0xf bank_mask:0xf
    v_and_b32_dpp v29, v58, v5 row_newbcast:0 row_mask:0xf bank_mask:0xf
    v_and_b32_dpp v30, v58, v6 row_newbcast:0 row_mask:0xf bank_mask:0xf
    v_and_b32_dpp v31, v58, v7 row_newbcast:0 row_mask:0xf bank_mask:0xf
    s_waitcnt vmcnt(20)
    s_nop 0
    v_mfma_f32_16x16x32_bf16 v[24:27], v[28:31], a[0:3], v[24:27]
    buffer_load_dwordx4 a[0:3], v2, s[20:23], s41 offen offset:0 nt
    v_and_b32_dpp v32, v58, v4 row_newbcast:4 row_mask:0xf bank_mask:0xf
    v_and_b32_dpp v33, v58, v5 row_newbcast:4 row_mask:0xf bank_mask:0xf
    v_and_b32_dpp v34, v58, v6 row_newbcast:4 row_mask:0xf bank_mask:0xf
    v_and_b32_dpp v35, v58, v7 row_newbcast:4 row_mask:0xf bank_mask:0xf
    s_waitcnt vmcnt(20)
    s_nop 0
    v_mfma_f32_16x16x32_bf16 v[24:27], v[32:35], a[4:7], v[24:27]
    buffer_load_dwordx4 a[4:7], v2, s[20:23], s41 offen offset:1024 nt
    v_and_b32_dpp v36, v58, v4 row_newbcast:8 row_mask:0xf bank_mask:0xf
    v_and_b32_dpp v37, v58, v5 row_newbcast:8 row_mask:0xf bank_mask:0xf
    v_and_b32_dpp v38, v58, v6 row_newbcast:8 row_mask:0xf bank_mask:0xf
    v_and_b32_dpp v39, v58, v7 row_newbcast:8 row_mask:0xf bank_mask:0xf
    s_waitcnt vmcnt(20)
    s_nop 0
    v_mfma_f32_16x16x32_bf16 v[24:27], v[36:39], a[8:11], v[24:27]
    buffer_load_dwordx4 a[8:11], v2, s[20:23], s41 offen offset:2048 nt
    v_and_b32_dpp v40, v58, v4 row_newbcast:12 row_mask:0xf bank_mask:0xf
    v_and_b32_dpp v41, v58, v5 row_newbcast:12 row_mask:0xf bank_mask:0xf
    v_and_b32_dpp v42, v58, v6 row_newbcast:12 row_mask:0xf bank_mask:0xf
    v_and_b32_dpp v43, v58, v7 row_newbcast:12 row_mask:0xf bank_mask:0xf
    s_waitcnt vmcnt(20)
    s_nop 0
    v_mfma_f32_16x16x32_bf16 v[24:27], v[40:43], a[12:15], v[24:27]
    buffer_load_dwordx4 a[12:15], v2, s[20:23], s41 offen offset:3072 nt
    v_and_b32_dpp v28, v59, v4 row_newbcast:0 row_mask:0xf bank_mask:0xf
    v_and_b32_dpp v29, v59, v5 row_newbcast:0 row_mask:0xf bank_mask:0xf
    v_and_b32_dpp v30, v59, v6 row_newbcast:0 row_mask:0xf bank_mask:0xf
    v_and_b32_dpp v31, v59, v7 row_newbcast:0 row_mask:0xf bank_mask:0xf
    s_waitcnt vmcnt(20)
    s_nop 0
    v_mfma_f32_16x16x32_bf16 v[24:27], v[28:31], a[16:19], v[24:27]
    buffer_load_dwordx4 a[16:19], v2, s[20:23], s42 offen offset:0 nt
    v_and_b32_dpp v32, v59, v4 row_newbcast:4 row_mask:0xf bank_mask:0xf
    v_and_b32_dpp v33, v59, v5 row_newbcast:4 row_mask:0xf bank_mask:0xf
    v_and_b32_dpp v34, v59, v6 row_newbcast:4 row_mask:0xf bank_mask:0xf
    v_and_b32_dpp v35, v59, v7 row_newbcast:4 row_mask:0xf bank_mask:0xf
    s_waitcnt vmcnt(20)
    s_nop 0
    v_mfma_f32_16x16x32_bf16 v[24:27], v[32:35], a[20:23], v[24:27]
    buffer_load_dwordx4 a[20:23], v2, s[20:23], s42 offen offset:1024 nt
    v_and_b32_dpp v36, v59, v4 row_newbcast:8 row_mask:0xf bank_mask:0xf
    v_and_b32_dpp v37, v59, v5 row_newbcast:8 row_mask:0xf bank_mask:0xf
    v_and_b32_dpp v38, v59, v6 row_newbcast:8 row_mask:0xf bank_mask:0xf
    v_and_b32_dpp v39, v59, v7 row_newbcast:8 row_mask:0xf bank_mask:0xf
    s_waitcnt vmcnt(20)
    s_nop 0
    v_mfma_f32_16x16x32_bf16 v[24:27], v[36:39], a[24:27], v[24:27]
    buffer_load_dwordx4 a[24:27], v2, s[20:23], s42 offen offset:2048 nt
    v_and_b32_dpp v40, v59, v4 row_newbcast:12 row_mask:0xf bank_mask:0xf
    v_and_b32_dpp v41, v59, v5 row_newbcast:12 row_mask:0xf bank_mask:0xf
    v_and_b32_dpp v42, v59, v6 row_newbcast:12 row_mask:0xf bank_mask:0xf
    v_and_b32_dpp v43, v59, v7 row_newbcast:12 row_mask:0xf bank_mask:0xf
    s_waitcnt vmcnt(20)
    s_nop 0
    v_mfma_f32_16x16x32_bf16 v[24:27], v[40:43], a[28:31], v[24:27]
    buffer_load_dwordx4 a[28:31], v2, s[20:23], s42 offen offset:3072 nt
    v_and_b32_dpp v28, v60, v4 row_newbcast:0 row_mask:0xf bank_mask:0xf
    v_and_b32_dpp v29, v60, v5 row_newbcast:0 row_mask:0xf bank_mask:0xf
    v_and_b32_dpp v30, v60, v6 row_newbcast:0 row_mask:0xf bank_mask:0xf
    v_and_b32_dpp v31, v60, v7 row_newbcast:0 row_mask:0xf bank_mask:0xf
    s_waitcnt vmcnt(20)
    s_nop 0
    v_mfma_f32_16x16x32_bf16 v[24:27], v[28:31], a[32:35], v[24:27]
    buffer_load_dwordx4 a[32:35], v2, s[20:23], s43 offen offset:0 nt
    v_and_b32_dpp v32, v60, v4 row_newbcast:4 row_mask:0xf bank_mask:0xf
    v_and_b32_dpp v33, v60, v5 row_newbcast:4 row_mask:0xf bank_mask:0xf
    v_and_b32_dpp v34, v60, v6 row_newbcast:4 row_mask:0xf bank_mask:0xf
    v_and_b32_dpp v35, v60, v7 row_newbcast:4 row_mask:0xf bank_mask:0xf
    s_waitcnt vmcnt(20)
    s_nop 0
    v_mfma_f32_16x16x32_bf16 v[24:27], v[32:35], a[36:39], v[24:27]
    buffer_load_dwordx4 a[36:39], v2, s[20:23], s43 offen offset:1024 nt
    v_and_b32_dpp v36, v60, v4 row_newbcast:8 row_mask:0xf bank_mask:0xf
    v_and_b32_dpp v37, v60, v5 row_newbcast:8 row_mask:0xf bank_mask:0xf
    v_and_b32_dpp v38, v60, v6 row_newbcast:8 row_mask:0xf bank_mask:0xf
    v_and_b32_dpp v39, v60, v7 row_newbcast:8 row_mask:0xf bank_mask:0xf
    s_waitcnt vmcnt(20)
    s_nop 0
    v_mfma_f32_16x16x32_bf16 v[24:27], v[36:39], a[40:43], v[24:27]
    buffer_load_dwordx4 a[40:43], v2, s[20:23], s43 offen offset:2048 nt
    v_and_b32_dpp v40, v60, v4 row_newbcast:12 row_mask:0xf bank_mask:0xf
    v_and_b32_dpp v41, v60, v5 row_newbcast:12 row_mask:0xf bank_mask:0xf
    v_and_b32_dpp v42, v60, v6 row_newbcast:12 row_mask:0xf bank_mask:0xf
    v_and_b32_dpp v43, v60, v7 row_newbcast:12 row_mask:0xf bank_mask:0xf
    s_waitcnt vmcnt(20)
    s_nop 0
    v_mfma_f32_16x16x32_bf16 v[24:27], v[40:43], a[44:47], v[24:27]
    buffer_load_dwordx4 a[44:47], v2, s[20:23], s43 offen offset:3072 nt
    s_branch L_bottom
.p2align 6
L_deep:
    v_mov_b32 v78, s44
    s_mov_b64 exec, 1
    global_store_dword v77, v78, s[48:49]
    s_mov_b64 exec, -1
    global_load_dword v79, v76, s[48:49] sc1
    s_waitcnt vmcnt(24)
    v_mfma_f32_16x16x32_bf16 v[64:67], v[80:83], v[8:11], 0
    s_bitcmp1_b32 s34, 15
    s_cselect_b32 s41, 0x20a000, 0
    s_xor_b32 s41, s41, s40
    s_xor_b32 s41, s41, s34
    s_add_u32 s34, s34, 0x2000
    s_or_b32 s34, s34, 0x204000
    buffer_load_dwordx4 v[80:83], v1, s[16:19], s41 offen offset:0 nt
    s_waitcnt vmcnt(24)
    v_mfma_f32_16x16x32_bf16 v[64:67], v[84:87], v[12:15], v[64:67]
    buffer_load_dwordx4 v[84:87], v1, s[16:19], s41 offen offset:1024 nt
    s_waitcnt vmcnt(24)
    v_mfma_f32_16x16x32_bf16 v[64:67], v[88:91], v[16:19], v[64:67]
    buffer_load_dwordx4 v[88:91], v1, s[16:19], s41 offen offset:2048 nt
    s_waitcnt vmcnt(24)
    v_mfma_f32_16x16x32_bf16 v[64:67], v[92:95], v[20:23], v[64:67]
    buffer_load_dwordx4 v[92:95], v1, s[16:19], s41 offen offset:3072 nt
    s_waitcnt vmcnt(24)
    v_mfma_f32_16x16x32_bf16 v[68:71], v[96:99], v[8:11], 0
    s_bitcmp1_b32 s34, 15
    s_cselect_b32 s42, 0x20a000, 0
    s_xor_b32 s42, s42, s40
    s_xor_b32 s42, s42, s34
    s_add_u32 s34, s34, 0x2000
    s_or_b32 s34, s34, 0x204000
    buffer_load_dwordx4 v[96:99], v1, s[16:19], s42 offen offset:0 nt
    s_waitcnt vmcnt(24)
    v_mfma_f32_16x16x32_bf16 v[68:71], v[100:103], v[12:15], v[68:71]
    buffer_load_dwordx4 v[100:103], v1, s[16:19], s42 offen offset:1024 nt
    s_waitcnt vmcnt(24)
    v_mfma_f32_16x16x32_bf16 v[68:71], v[104:107], v[16:19], v[68:71]
    buffer_load_dwordx4 v[104:107], v1, s[16:19], s42 offen offset:2048 nt
    v_mov_b32_dpp v45, v64 quad_perm:[0,0,0,0] row_mask:0xf bank_mask:0xf
    v_mov_b32_dpp v46, v66 quad_perm:[2,2,2,2] row_mask:0xf bank_mask:0xf
    s_waitcnt vmcnt(24)
    v_mfma_f32_16x16x32_bf16 v[68:71], v[108:111], v[20:23], v[68:71]
    buffer_load_dwordx4 v[108:111], v1, s[16:19], s42 offen offset:3072 nt
    v_add_f32_dpp v45, v65, v45 quad_perm:[1,1,1,1] row_mask:0xf bank_mask:0xf
    v_add_f32_dpp v46, v67, v46 quad_perm:[3,3,3,3] row_mask:0xf bank_mask:0xf
    v_add_f32 v54, v45, v46
    v_cvt_pk_bf16_f32 v54, 0, v54
    v_mul_f32 v54, 0x3db504f3, v54
    v_cvt_pk_bf16_f32 v54, 0, v54
    v_mul_f32 v54, v47, v54
    s_waitcnt vmcnt(24)
    v_mfma_f32_16x16x32_bf16 v[72:75], v[112:115], v[8:11], 0
    s_bitcmp1_b32 s34, 15
    s_cselect_b32 s43, 0x20a000, 0
    s_xor_b32 s43, s43, s40
    s_xor_b32 s43, s43, s34
    s_add_u32 s34, s34, 0x2000
    s_or_b32 s34, s34, 0x204000
    buffer_load_dwordx4 v[112:115], v1, s[16:19], s43 offen offset:0 nt
    s_waitcnt vmcnt(24)
    v_mfma_f32_16x16x32_bf16 v[72:75], v[116:119], v[12:15], v[72:75]
    buffer_load_dwordx4 v[116:119], v1, s[16:19], s43 offen offset:1024 nt
    s_waitcnt vmcnt(24)
    v_mfma_f32_16x16x32_bf16 v[72:75], v[120:123], v[16:19], v[72:75]
    buffer_load_dwordx4 v[120:123], v1, s[16:19], s43 offen offset:2048 nt
    v_mov_b32_dpp v45, v68 quad_perm:[0,0,0,0] row_mask:0xf bank_mask:0xf
    v_mov_b32_dpp v46, v70 quad_perm:[2,2,2,2] row_mask:0xf bank_mask:0xf
    s_waitcnt vmcnt(24)
    v_mfma_f32_16x16x32_bf16 v[72:75], v[124:127], v[20:23], v[72:75]
    buffer_load_dwordx4 v[124:127], v1, s[16:19], s43 offen offset:3072 nt
    v_add_f32_dpp v45, v69, v45 quad_perm:[1,1,1,1] row_mask:0xf bank_mask:0xf
    v_add_f32_dpp v46, v71, v46 quad_perm:[3,3,3,3] row_mask:0xf bank_mask:0xf
    v_add_f32 v55, v45, v46
    v_cvt_pk_bf16_f32 v55, 0, v55
    v_mul_f32 v55, 0x3db504f3, v55
    v_cvt_pk_bf16_f32 v55, 0, v55
    v_mul_f32 v55, v47, v55
    v_mov_b32_dpp v45, v72 quad_perm:[0,0,0,0] row_mask:0xf bank_mask:0xf
    v_mov_b32_dpp v46, v74 quad_perm:[2,2,2,2] row_mask:0xf bank_mask:0xf
    s_nop 0
    v_add_f32_dpp v45, v73, v45 quad_perm:[1,1,1,1] row_mask:0xf bank_mask:0xf
    v_add_f32_dpp v46, v75, v46 quad_perm:[3,3,3,3] row_mask:0xf bank_mask:0xf
    v_add_f32 v56, v45, v46
    v_cvt_pk_bf16_f32 v56, 0, v56
    v_mul_f32 v56, 0x3db504f3, v56
    v_cvt_pk_bf16_f32 v56, 0, v56
    v_mul_f32 v56, v47, v56
    v_max3_f32 v53, v54, v55, v56
    v_cmp_lt_f32 vcc, s28, v53
    s_cbranch_vccnz L_raise_2
L_keep_2:
    v_subrev_f32 v54, s28, v54
    v_subrev_f32 v55, s28, v55
    v_subrev_f32 v56, s28, v56
    v_exp_f32 v54, v54
    v_exp_f32 v55, v55
    v_exp_f32 v56, v56
    v_cvt_pk_bf16_f32 v58, v54, v54
    v_cvt_pk_bf16_f32 v59, v55, v55
    v_cvt_pk_bf16_f32 v60, v56, v56
    v_add_f32 v44, v54, v44
    v_add_f32 v44, v55, v44
    v_add_f32 v44, v56, v44
    v_and_b32_dpp v28, v58, v4 row_newbcast:0 row_mask:0xf bank_mask:0xf
    v_and_b32_dpp v29, v58, v5 row_newbcast:0 row_mask:0xf bank_mask:0xf
    v_and_b32_dpp v30, v58, v6 row_newbcast:0 row_mask:0xf bank_mask:0xf
    v_and_b32_dpp v31, v58, v7 row_newbcast:0 row_mask:0xf bank_mask:0xf
    s_waitcnt vmcnt(24)
    s_nop 0
    v_mfma_f32_16x16x32_bf16 v[24:27], v[28:31], a[0:3], v[24:27]
    buffer_load_dwordx4 a[0:3], v2, s[20:23], s41 offen offset:0 nt
    v_and_b32_dpp v32, v58, v4 row_newbcast:4 row_mask:0xf bank_mask:0xf
    v_and_b32_dpp v33, v58, v5 row_newbcast:4 row_mask:0xf bank_mask:0xf
    v_and_b32_dpp v34, v58, v6 row_newbcast:4 row_mask:0xf bank_mask:0xf
    v_and_b32_dpp v35, v58, v7 row_newbcast:4 row_mask:0xf bank_mask:0xf
    s_waitcnt vmcnt(24)
    s_nop 0
    v_mfma_f32_16x16x32_bf16 v[24:27], v[32:35], a[4:7], v[24:27]
    buffer_load_dwordx4 a[4:7], v2, s[20:23], s41 offen offset:1024 nt
    v_and_b32_dpp v36, v58, v4 row_newbcast:8 row_mask:0xf bank_mask:0xf
    v_and_b32_dpp v37, v58, v5 row_newbcast:8 row_mask:0xf bank_mask:0xf
    v_and_b32_dpp v38, v58, v6 row_newbcast:8 row_mask:0xf bank_mask:0xf
    v_and_b32_dpp v39, v58, v7 row_newbcast:8 row_mask:0xf bank_mask:0xf
    s_waitcnt vmcnt(24)
    s_nop 0
    v_mfma_f32_16x16x32_bf16 v[24:27], v[36:39], a[8:11], v[24:27]
    buffer_load_dwordx4 a[8:11], v2, s[20:23], s41 offen offset:2048 nt
    v_and_b32_dpp v40, v58, v4 row_newbcast:12 row_mask:0xf bank_mask:0xf
    v_and_b32_dpp v41, v58, v5 row_newbcast:12 row_mask:0xf bank_mask:0xf
    v_and_b32_dpp v42, v58, v6 row_newbcast:12 row_mask:0xf bank_mask:0xf
    v_and_b32_dpp v43, v58, v7 row_newbcast:12 row_mask:0xf bank_mask:0xf
    s_waitcnt vmcnt(24)
    s_nop 0
    v_mfma_f32_16x16x32_bf16 v[24:27], v[40:43], a[12:15], v[24:27]
    buffer_load_dwordx4 a[12:15], v2, s[20:23], s41 offen offset:3072 nt
    v_and_b32_dpp v28, v59, v4 row_newbcast:0 row_mask:0xf bank_mask:0xf
    v_and_b32_dpp v29, v59, v5 row_newbcast:0 row_mask:0xf bank_mask:0xf
    v_and_b32_dpp v30, v59, v6 row_newbcast:0 row_mask:0xf bank_mask:0xf
    v_and_b32_dpp v31, v59, v7 row_newbcast:0 row_mask:0xf bank_mask:0xf
    s_waitcnt vmcnt(24)
    s_nop 0
    v_mfma_f32_16x16x32_bf16 v[24:27], v[28:31], a[16:19], v[24:27]
    buffer_load_dwordx4 a[16:19], v2, s[20:23], s42 offen offset:0 nt
    v_and_b32_dpp v32, v59, v4 row_newbcast:4 row_mask:0xf bank_mask:0xf
    v_and_b32_dpp v33, v59, v5 row_newbcast:4 row_mask:0xf bank_mask:0xf
    v_and_b32_dpp v34, v59, v6 row_newbcast:4 row_mask:0xf bank_mask:0xf
    v_and_b32_dpp v35, v59, v7 row_newbcast:4 row_mask:0xf bank_mask:0xf
    s_waitcnt vmcnt(24)
    s_nop 0
    v_mfma_f32_16x16x32_bf16 v[24:27], v[32:35], a[20:23], v[24:27]
    buffer_load_dwordx4 a[20:23], v2, s[20:23], s42 offen offset:1024 nt
    v_and_b32_dpp v36, v59, v4 row_newbcast:8 row_mask:0xf bank_mask:0xf
    v_and_b32_dpp v37, v59, v5 row_newbcast:8 row_mask:0xf bank_mask:0xf
    v_and_b32_dpp v38, v59, v6 row_newbcast:8 row_mask:0xf bank_mask:0xf
    v_and_b32_dpp v39, v59, v7 row_newbcast:8 row_mask:0xf bank_mask:0xf
    s_waitcnt vmcnt(24)
    s_nop 0
    v_mfma_f32_16x16x32_bf16 v[24:27], v[36:39], a[24:27], v[24:27]
    buffer_load_dwordx4 a[24:27], v2, s[20:23], s42 offen offset:2048 nt
    v_and_b32_dpp v40, v59, v4 row_newbcast:12 row_mask:0xf bank_mask:0xf
    v_and_b32_dpp v41, v59, v5 row_newbcast:12 row_mask:0xf bank_mask:0xf
    v_and_b32_dpp v42, v59, v6 row_newbcast:12 row_mask:0xf bank_mask:0xf
    v_and_b32_dpp v43, v59, v7 row_newbcast:12 row_mask:0xf bank_mask:0xf
    s_waitcnt vmcnt(24)
    s_nop 0
    v_mfma_f32_16x16x32_bf16 v[24:27], v[40:43], a[28:31], v[24:27]
    buffer_load_dwordx4 a[28:31], v2, s[20:23], s42 offen offset:3072 nt
    v_and_b32_dpp v28, v60, v4 row_newbcast:0 row_mask:0xf bank_mask:0xf
    v_and_b32_dpp v29, v60, v5 row_newbcast:0 row_mask:0xf bank_mask:0xf
    v_and_b32_dpp v30, v60, v6 row_newbcast:0 row_mask:0xf bank_mask:0xf
    v_and_b32_dpp v31, v60, v7 row_newbcast:0 row_mask:0xf bank_mask:0xf
    s_waitcnt vmcnt(24)
    s_nop 0
    v_mfma_f32_16x16x32_bf16 v[24:27], v[28:31], a[32:35], v[24:27]
    buffer_load_dwordx4 a[32:35], v2, s[20:23], s43 offen offset:0 nt
    v_and_b32_dpp v32, v60, v4 row_newbcast:4 row_mask:0xf bank_mask:0xf
    v_and_b32_dpp v33, v60, v5 row_newbcast:4 row_mask:0xf bank_mask:0xf
    v_and_b32_dpp v34, v60, v6 row_newbcast:4 row_mask:0xf bank_mask:0xf
    v_and_b32_dpp v35, v60, v7 row_newbcast:4 row_mask:0xf bank_mask:0xf
    s_waitcnt vmcnt(24)
    s_nop 0
    v_mfma_f32_16x16x32_bf16 v[24:27], v[32:35], a[36:39], v[24:27]
    buffer_load_dwordx4 a[36:39], v2, s[20:23], s43 offen offset:1024 nt
    v_and_b32_dpp v36, v60, v4 row_newbcast:8 row_mask:0xf bank_mask:0xf
    v_and_b32_dpp v37, v60, v5 row_newbcast:8 row_mask:0xf bank_mask:0xf
    v_and_b32_dpp v38, v60, v6 row_newbcast:8 row_mask:0xf bank_mask:0xf
    v_and_b32_dpp v39, v60, v7 row_newbcast:8 row_mask:0xf bank_mask:0xf
    s_waitcnt vmcnt(24)
    s_nop 0
    v_mfma_f32_16x16x32_bf16 v[24:27], v[36:39], a[40:43], v[24:27]
    buffer_load_dwordx4 a[40:43], v2, s[20:23], s43 offen offset:2048 nt
    v_and_b32_dpp v40, v60, v4 row_newbcast:12 row_mask:0xf bank_mask:0xf
    v_and_b32_dpp v41, v60, v5 row_newbcast:12 row_mask:0xf bank_mask:0xf
    v_and_b32_dpp v42, v60, v6 row_newbcast:12 row_mask:0xf bank_mask:0xf
    v_and_b32_dpp v43, v60, v7 row_newbcast:12 row_mask:0xf bank_mask:0xf
    s_waitcnt vmcnt(24)
    s_nop 0
    v_mfma_f32_16x16x32_bf16 v[24:27], v[40:43], a[44:47], v[24:27]
    buffer_load_dwordx4 a[44:47], v2, s[20:23], s43 offen offset:3072 nt
L_bottom:
    s_waitcnt vmcnt(24)
    v_subrev_u32 v45, s44, v79
    v_add_u32 v46, 32, v45
    v_cmp_le_i32 vcc, 0, v45
    s_add_u32 s44, s44, 1
    s_bcnt1_i32_b64 s30, vcc
    v_cmp_gt_u32 vcc, 64, v46
    s_cmp_lt_u32 s30, 44
    s_cselect_b32 s30, 1, 0
    s_mov_b32 s45, 1
    s_cmp_eq_u64 vcc, -1
    s_cselect_b32 s45, s30, s45
    s_sub_u32 s27, s27, 1
    s_sub_u32 s30, s27, 2
    s_cmp_lt_u32 s30, s46
    s_cbranch_scc0 L_event
L_pick:
    s_cmp_eq_u32 s45, 0
    s_cbranch_scc1 L_deep
    s_branch L_shallow
L_event:
    s_cmp_eq_u32 s35, 0
    s_cbranch_scc1 L_tag
L_tagged:
    s_cmp_eq_u32 s27, 1
    s_cbranch_scc1 L_claim
    s_waitcnt lgkmcnt(0)
    s_bfe_u32 s40, s33, 0x10000
    s_lshl_b32 s40, s40, 15
    s_bfe_u32 s31, s33, 0x10001
    s_lshl_b32 s31, s31, 12
    s_or_b32 s40, s40, s31
    s_bfe_u32 s31, s33, 0x10002
    s_lshl_b32 s31, s31, 14
    s_or_b32 s40, s40, s31
    s_xor_b32 s40, s40, s50
    s_lshr_b32 s30, s33, 3
    s_mul_i32 s30, s30, 6
    s_lshr_b32 s27, 0x41083, s30
    s_and_b32 s27, s27, 63
    s_lshr_b32 s30, 0x1850c0, s30
    s_and_b32 s30, s30, 63
    s_mul_i32 s30, s30, 3
    s_add_u32 s30, s30, 492
    s_bfe_u32 s34, s30, 0x10000
    s_lshl_b32 s34, s34, 13
    s_bfe_u32 s31, s30, 0x60001
    s_lshl_b32 s31, s31, 15
    s_or_b32 s34, s34, s31
    s_bfe_u32 s31, s30, 0x20007
    s_lshl_b32 s31, s31, 22
    s_or_b32 s34, s34, s31
    s_or_b32 s34, s34, 0x204000
    s_cmp_ge_u32 s33, 24
    s_cbranch_scc1 L_final
    s_cmp_gt_u32 s27, 1
    s_cbranch_scc1 L_pick
L_claim:
    s_mov_b32 s33, 1
    s_atomic_add s33, s[36:37], 0 glc
    s_branch L_pick
L_final:
    s_bitcmp1_b32 s34, 15
    s_cselect_b32 s41, 0x20a000, 0
    s_xor_b32 s41, s41, s40
    s_xor_b32 s41, s41, s34
    s_add_u32 s34, s34, 0x2000
    s_or_b32 s34, s34, 0x204000
    buffer_load_dwordx4 v[128:131], v1, s[16:19], s41 offen offset:0 nt
    buffer_load_dwordx4 v[132:135], v1, s[16:19], s41 offen offset:1024 nt
    buffer_load_dwordx4 v[136:139], v1, s[16:19], s41 offen offset:2048 nt
    buffer_load_dwordx4 v[140:143], v1, s[16:19], s41 offen offset:3072 nt
    s_bitcmp1_b32 s34, 15
    s_cselect_b32 s42, 0x20a000, 0
    s_xor_b32 s42, s42, s40
    s_xor_b32 s42, s42, s34
    s_add_u32 s34, s34, 0x2000
    s_or_b32 s34, s34, 0x204000
    buffer_load_dwordx4 v[144:147], v1, s[16:19], s42 offen offset:0 nt
    buffer_load_dwordx4 v[148:151], v1, s[16:19], s42 offen offset:1024 nt
    buffer_load_dwordx4 v[152:155], v1, s[16:19], s42 offen offset:2048 nt
    buffer_load_dwordx4 v[156:159], v1, s[16:19], s42 offen offset:3072 nt
    buffer_load_dwordx4 a[48:51], v2, s[20:23], s41 offen offset:0 nt
    buffer_load_dwordx4 a[52:55], v2, s[20:23], s41 offen offset:1024 nt
    buffer_load_dwordx4 a[56:59], v2, s[20:23], s41 offen offset:2048 nt
    buffer_load_dwordx4 a[60:63], v2, s[20:23], s41 offen offset:3072 nt
    buffer_load_dwordx4 a[64:67], v2, s[20:23], s42 offen offset:0 nt
    buffer_load_dwordx4 a[68:71], v2, s[20:23], s42 offen offset:1024 nt
    buffer_load_dwordx4 a[72:75], v2, s[20:23], s42 offen offset:2048 nt
    buffer_load_dwordx4 a[76:79], v2, s[20:23], s42 offen offset:3072 nt
    s_waitcnt vmcnt(39)
    v_mfma_f32_16x16x32_bf16 v[64:67], v[80:83], v[8:11], 0
    s_waitcnt vmcnt(38)
    v_mfma_f32_16x16x32_bf16 v[64:67], v[84:87], v[12:15], v[64:67]
    s_waitcnt vmcnt(37)
    v_mfma_f32_16x16x32_bf16 v[64:67], v[88:91], v[16:19], v[64:67]
    s_waitcnt vmcnt(36)
    v_mfma_f32_16x16x32_bf16 v[64:67], v[92:95], v[20:23], v[64:67]
    s_waitcnt vmcnt(35)
    v_mfma_f32_16x16x32_bf16 v[68:71], v[96:99], v[8:11], 0
    s_waitcnt vmcnt(34)
    v_mfma_f32_16x16x32_bf16 v[68:71], v[100:103], v[12:15], v[68:71]
    s_waitcnt vmcnt(33)
    v_mfma_f32_16x16x32_bf16 v[68:71], v[104:107], v[16:19], v[68:71]
    s_nop 1
    v_mov_b32_dpp v45, v64 quad_perm:[0,0,0,0] row_mask:0xf bank_mask:0xf
    v_mov_b32_dpp v46, v66 quad_perm:[2,2,2,2] row_mask:0xf bank_mask:0xf
    s_waitcnt vmcnt(32)
    v_mfma_f32_16x16x32_bf16 v[68:71], v[108:111], v[20:23], v[68:71]
    v_add_f32_dpp v45, v65, v45 quad_perm:[1,1,1,1] row_mask:0xf bank_mask:0xf
    v_add_f32_dpp v46, v67, v46 quad_perm:[3,3,3,3] row_mask:0xf bank_mask:0xf
    v_add_f32 v54, v45, v46
    v_cvt_pk_bf16_f32 v54, 0, v54
    v_mul_f32 v54, 0x3db504f3, v54
    v_cvt_pk_bf16_f32 v54, 0, v54
    v_mul_f32 v54, v47, v54
    s_waitcnt vmcnt(31)
    v_mfma_f32_16x16x32_bf16 v[72:75], v[112:115], v[8:11], 0
    s_waitcnt vmcnt(30)
    v_mfma_f32_16x16x32_bf16 v[72:75], v[116:119], v[12:15], v[72:75]
    s_waitcnt vmcnt(29)
    v_mfma_f32_16x16x32_bf16 v[72:75], v[120:123], v[16:19], v[72:75]
    s_nop 1
    v_mov_b32_dpp v45, v68 quad_perm:[0,0,0,0] row_mask:0xf bank_mask:0xf
    v_mov_b32_dpp v46, v70 quad_perm:[2,2,2,2] row_mask:0xf bank_mask:0xf
    s_waitcnt vmcnt(28)
    v_mfma_f32_16x16x32_bf16 v[72:75], v[124:127], v[20:23], v[72:75]
    v_add_f32_dpp v45, v69, v45 quad_perm:[1,1,1,1] row_mask:0xf bank_mask:0xf
    v_add_f32_dpp v46, v71, v46 quad_perm:[3,3,3,3] row_mask:0xf bank_mask:0xf
    v_add_f32 v55, v45, v46
    v_cvt_pk_bf16_f32 v55, 0, v55
    v_mul_f32 v55, 0x3db504f3, v55
    v_cvt_pk_bf16_f32 v55, 0, v55
    v_mul_f32 v55, v47, v55
    s_nop 0
    v_mov_b32_dpp v45, v72 quad_perm:[0,0,0,0] row_mask:0xf bank_mask:0xf
    v_mov_b32_dpp v46, v74 quad_perm:[2,2,2,2] row_mask:0xf bank_mask:0xf
    s_nop 0
    v_add_f32_dpp v45, v73, v45 quad_perm:[1,1,1,1] row_mask:0xf bank_mask:0xf
    v_add_f32_dpp v46, v75, v46 quad_perm:[3,3,3,3] row_mask:0xf bank_mask:0xf
    v_add_f32 v56, v45, v46
    v_cvt_pk_bf16_f32 v56, 0, v56
    v_mul_f32 v56, 0x3db504f3, v56
    v_cvt_pk_bf16_f32 v56, 0, v56
    v_mul_f32 v56, v47, v56
    v_max3_f32 v53, v54, v55, v56
    v_cmp_lt_f32 vcc, s28, v53
    s_cbranch_vccnz L_raise_3
L_keep_3:
    v_subrev_f32 v54, s28, v54
    v_subrev_f32 v55, s28, v55
    v_subrev_f32 v56, s28, v56
    v_exp_f32 v54, v54
    v_exp_f32 v55, v55
    v_exp_f32 v56, v56
    v_cvt_pk_bf16_f32 v58, v54, v54
    v_cvt_pk_bf16_f32 v59, v55, v55
    v_cvt_pk_bf16_f32 v60, v56, v56
    v_add_f32 v44, v54, v44
    v_add_f32 v44, v55, v44
    v_add_f32 v44, v56, v44
    v_and_b32_dpp v28, v58, v4 row_newbcast:0 row_mask:0xf bank_mask:0xf
    v_and_b32_dpp v29, v58, v5 row_newbcast:0 row_mask:0xf bank_mask:0xf
    v_and_b32_dpp v30, v58, v6 row_newbcast:0 row_mask:0xf bank_mask:0xf
    v_and_b32_dpp v31, v58, v7 row_newbcast:0 row_mask:0xf bank_mask:0xf
    s_waitcnt vmcnt(27)
    s_nop 0
    v_mfma_f32_16x16x32_bf16 v[24:27], v[28:31], a[0:3], v[24:27]
    v_and_b32_dpp v32, v58, v4 row_newbcast:4 row_mask:0xf bank_mask:0xf
    v_and_b32_dpp v33, v58, v5 row_newbcast:4 row_mask:0xf bank_mask:0xf
    v_and_b32_dpp v34, v58, v6 row_newbcast:4 row_mask:0xf bank_mask:0xf
    v_and_b32_dpp v35, v58, v7 row_newbcast:4 row_mask:0xf bank_mask:0xf
    s_waitcnt vmcnt(26)
    s_nop 0
    v_mfma_f32_16x16x32_bf16 v[24:27], v[32:35], a[4:7], v[24:27]
    v_and_b32_dpp v36, v58, v4 row_newbcast:8 row_mask:0xf bank_mask:0xf
    v_and_b32_dpp v37, v58, v5 row_newbcast:8 row_mask:0xf bank_mask:0xf
    v_and_b32_dpp v38, v58, v6 row_newbcast:8 row_mask:0xf bank_mask:0xf
    v_and_b32_dpp v39, v58, v7 row_newbcast:8 row_mask:0xf bank_mask:0xf
    s_waitcnt vmcnt(25)
    s_nop 0
    v_mfma_f32_16x16x32_bf16 v[24:27], v[36:39], a[8:11], v[24:27]
    v_and_b32_dpp v40, v58, v4 row_newbcast:12 row_mask:0xf bank_mask:0xf
    v_and_b32_dpp v41, v58, v5 row_newbcast:12 row_mask:0xf bank_mask:0xf
    v_and_b32_dpp v42, v58, v6 row_newbcast:12 row_mask:0xf bank_mask:0xf
    v_and_b32_dpp v43, v58, v7 row_newbcast:12 row_mask:0xf bank_mask:0xf
    s_waitcnt vmcnt(24)
    s_nop 0
    v_mfma_f32_16x16x32_bf16 v[24:27], v[40:43], a[12:15], v[24:27]
    v_and_b32_dpp v28, v59, v4 row_newbcast:0 row_mask:0xf bank_mask:0xf
    v_and_b32_dpp v29, v59, v5 row_newbcast:0 row_mask:0xf bank_mask:0xf
    v_and_b32_dpp v30, v59, v6 row_newbcast:0 row_mask:0xf bank_mask:0xf
    v_and_b32_dpp v31, v59, v7 row_newbcast:0 row_mask:0xf bank_mask:0xf
    s_waitcnt vmcnt(23)
    s_nop 0
    v_mfma_f32_16x16x32_bf16 v[24:27], v[28:31], a[16:19], v[24:27]
    v_and_b32_dpp v32, v59, v4 row_newbcast:4 row_mask:0xf bank_mask:0xf
    v_and_b32_dpp v33, v59, v5 row_newbcast:4 row_mask:0xf bank_mask:0xf
    v_and_b32_dpp v34, v59, v6 row_newbcast:4 row_mask:0xf bank_mask:0xf
    v_and_b32_dpp v35, v59, v7 row_newbcast:4 row_mask:0xf bank_mask:0xf
    s_waitcnt vmcnt(22)
    s_nop 0
    v_mfma_f32_16x16x32_bf16 v[24:27], v[32:35], a[20:23], v[24:27]
    v_and_b32_dpp v36, v59, v4 row_newbcast:8 row_mask:0xf bank_mask:0xf
    v_and_b32_dpp v37, v59, v5 row_newbcast:8 row_mask:0xf bank_mask:0xf
    v_and_b32_dpp v38, v59, v6 row_newbcast:8 row_mask:0xf bank_mask:0xf
    v_and_b32_dpp v39, v59, v7 row_newbcast:8 row_mask:0xf bank_mask:0xf
    s_waitcnt vmcnt(21)
    s_nop 0
    v_mfma_f32_16x16x32_bf16 v[24:27], v[36:39], a[24:27], v[24:27]
    v_and_b32_dpp v40, v59, v4 row_newbcast:12 row_mask:0xf bank_mask:0xf
    v_and_b32_dpp v41, v59, v5 row_newbcast:12 row_mask:0xf bank_mask:0xf
    v_and_b32_dpp v42, v59, v6 row_newbcast:12 row_mask:0xf bank_mask:0xf
    v_and_b32_dpp v43, v59, v7 row_newbcast:12 row_mask:0xf bank_mask:0xf
    s_waitcnt vmcnt(20)
    s_nop 0
    v_mfma_f32_16x16x32_bf16 v[24:27], v[40:43], a[28:31], v[24:27]
    v_and_b32_dpp v28, v60, v4 row_newbcast:0 row_mask:0xf bank_mask:0xf
    v_and_b32_dpp v29, v60, v5 row_newbcast:0 row_mask:0xf bank_mask:0xf
    v_and_b32_dpp v30, v60, v6 row_newbcast:0 row_mask:0xf bank_mask:0xf
    v_and_b32_dpp v31, v60, v7 row_newbcast:0 row_mask:0xf bank_mask:0xf
    s_waitcnt vmcnt(19)
    s_nop 0
    v_mfma_f32_16x16x32_bf16 v[24:27], v[28:31], a[32:35], v[24:27]
    v_and_b32_dpp v32, v60, v4 row_newbcast:4 row_mask:0xf bank_mask:0xf
    v_and_b32_dpp v33, v60, v5 row_newbcast:4 row_mask:0xf bank_mask:0xf
    v_and_b32_dpp v34, v60, v6 row_newbcast:4 row_mask:0xf bank_mask:0xf
    v_and_b32_dpp v35, v60, v7 row_newbcast:4 row_mask:0xf bank_mask:0xf
    s_waitcnt vmcnt(18)
    s_nop 0
    v_mfma_f32_16x16x32_bf16 v[24:27], v[32:35], a[36:39], v[24:27]
    v_and_b32_dpp v36, v60, v4 row_newbcast:8 row_mask:0xf bank_mask:0xf
    v_and_b32_dpp v37, v60, v5 row_newbcast:8 row_mask:0xf bank_mask:0xf
    v_and_b32_dpp v38, v60, v6 row_newbcast:8 row_mask:0xf bank_mask:0xf
    v_and_b32_dpp v39, v60, v7 row_newbcast:8 row_mask:0xf bank_mask:0xf
    s_waitcnt vmcnt(17)
    s_nop 0
    v_mfma_f32_16x16x32_bf16 v[24:27], v[36:39], a[40:43], v[24:27]
    v_and_b32_dpp v40, v60, v4 row_newbcast:12 row_mask:0xf bank_mask:0xf
    v_and_b32_dpp v41, v60, v5 row_newbcast:12 row_mask:0xf bank_mask:0xf
    v_and_b32_dpp v42, v60, v6 row_newbcast:12 row_mask:0xf bank_mask:0xf
    v_and_b32_dpp v43, v60, v7 row_newbcast:12 row_mask:0xf bank_mask:0xf
    s_waitcnt vmcnt(16)
    s_nop 0
    v_mfma_f32_16x16x32_bf16 v[24:27], v[40:43], a[44:47], v[24:27]
    s_waitcnt vmcnt(15)
    v_mfma_f32_16x16x32_bf16 v[64:67], v[128:131], v[8:11], 0
    s_waitcnt vmcnt(14)
    v_mfma_f32_16x16x32_bf16 v[64:67], v[132:135], v[12:15], v[64:67]
    s_waitcnt vmcnt(13)
    v_mfma_f32_16x16x32_bf16 v[64:67], v[136:139], v[16:19], v[64:67]
    s_waitcnt vmcnt(12)
    v_mfma_f32_16x16x32_bf16 v[64:67], v[140:143], v[20:23], v[64:67]
    s_waitcnt vmcnt(11)
    v_mfma_f32_16x16x32_bf16 v[68:71], v[144:147], v[8:11], 0
    s_waitcnt vmcnt(10)
    v_mfma_f32_16x16x32_bf16 v[68:71], v[148:151], v[12:15], v[68:71]
    s_waitcnt vmcnt(9)
    v_mfma_f32_16x16x32_bf16 v[68:71], v[152:155], v[16:19], v[68:71]
    s_nop 1
    v_mov_b32_dpp v45, v64 quad_perm:[0,0,0,0] row_mask:0xf bank_mask:0xf
    v_mov_b32_dpp v46, v66 quad_perm:[2,2,2,2] row_mask:0xf bank_mask:0xf
    s_waitcnt vmcnt(8)
    v_mfma_f32_16x16x32_bf16 v[68:71], v[156:159], v[20:23], v[68:71]
    v_add_f32_dpp v45, v65, v45 quad_perm:[1,1,1,1] row_mask:0xf bank_mask:0xf
    v_add_f32_dpp v46, v67, v46 quad_perm:[3,3,3,3] row_mask:0xf bank_mask:0xf
    v_add_f32 v54, v45, v46
    v_cvt_pk_bf16_f32 v54, 0, v54
    v_mul_f32 v54, 0x3db504f3, v54
    v_cvt_pk_bf16_f32 v54, 0, v54
    v_mul_f32 v54, v47, v54
    s_nop 0
    v_mov_b32_dpp v45, v68 quad_perm:[0,0,0,0] row_mask:0xf bank_mask:0xf
    v_mov_b32_dpp v46, v70 quad_perm:[2,2,2,2] row_mask:0xf bank_mask:0xf
    s_nop 0
    v_add_f32_dpp v45, v69, v45 quad_perm:[1,1,1,1] row_mask:0xf bank_mask:0xf
    v_add_f32_dpp v46, v71, v46 quad_perm:[3,3,3,3] row_mask:0xf bank_mask:0xf
    v_add_f32 v55, v45, v46
    v_cvt_pk_bf16_f32 v55, 0, v55
    v_mul_f32 v55, 0x3db504f3, v55
    v_cvt_pk_bf16_f32 v55, 0, v55
    v_mul_f32 v55, v47, v55
    v_max_f32 v53, v54, v55
    v_cmp_lt_f32 vcc, s28, v53
    s_cbranch_vccnz L_raise_4
L_keep_4:
    v_subrev_f32 v54, s28, v54
    v_subrev_f32 v55, s28, v55
    v_exp_f32 v54, v54
    v_exp_f32 v55, v55
    v_cvt_pk_bf16_f32 v58, v54, v54
    v_cvt_pk_bf16_f32 v59, v55, v55
    v_add_f32 v44, v54, v44
    v_add_f32 v44, v55, v44
    s_nop 1
    v_add_f32_dpp v48, v44, v44 row_ror:4 row_mask:0xf bank_mask:0xf
    s_nop 1
    v_add_f32_dpp v48, v48, v48 row_ror:8 row_mask:0xf bank_mask:0xf
    s_nop 1
    v_add_f32_dpp v48, v48, v48 row_bcast:15 row_mask:0xa bank_mask:0xf
    s_nop 1
    v_add_f32_dpp v48, v48, v48 row_bcast:31 row_mask:0xc bank_mask:0xf
    s_nop 1
    v_readlane_b32 s32, v48, 63
    v_xor_b32 v9, 1024, v51
    v_xor_b32 v10, 2048, v51
    v_xor_b32 v11, 3072, v51
    v_xor_b32 v12, 4096, v51
    v_xor_b32 v13, 5120, v51
    v_xor_b32 v14, 6144, v51
    v_xor_b32 v15, 7168, v51
    v_and_b32_dpp v28, v58, v4 row_newbcast:0 row_mask:0xf bank_mask:0xf
    v_and_b32_dpp v29, v58, v5 row_newbcast:0 row_mask:0xf bank_mask:0xf
    v_and_b32_dpp v30, v58, v6 row_newbcast:0 row_mask:0xf bank_mask:0xf
    v_and_b32_dpp v31, v58, v7 row_newbcast:0 row_mask:0xf bank_mask:0xf
    s_waitcnt vmcnt(7)
    s_nop 0
    v_mfma_f32_16x16x32_bf16 v[24:27], v[28:31], a[48:51], v[24:27]
    v_and_b32_dpp v32, v58, v4 row_newbcast:4 row_mask:0xf bank_mask:0xf
    v_and_b32_dpp v33, v58, v5 row_newbcast:4 row_mask:0xf bank_mask:0xf
    v_and_b32_dpp v34, v58, v6 row_newbcast:4 row_mask:0xf bank_mask:0xf
    v_and_b32_dpp v35, v58, v7 row_newbcast:4 row_mask:0xf bank_mask:0xf
    s_waitcnt vmcnt(6)
    s_nop 0
    v_mfma_f32_16x16x32_bf16 v[24:27], v[32:35], a[52:55], v[24:27]
    v_and_b32_dpp v36, v58, v4 row_newbcast:8 row_mask:0xf bank_mask:0xf
    v_and_b32_dpp v37, v58, v5 row_newbcast:8 row_mask:0xf bank_mask:0xf
    v_and_b32_dpp v38, v58, v6 row_newbcast:8 row_mask:0xf bank_mask:0xf
    v_and_b32_dpp v39, v58, v7 row_newbcast:8 row_mask:0xf bank_mask:0xf
    s_waitcnt vmcnt(5)
    s_nop 0
    v_mfma_f32_16x16x32_bf16 v[24:27], v[36:39], a[56:59], v[24:27]
    v_and_b32_dpp v40, v58, v4 row_newbcast:12 row_mask:0xf bank_mask:0xf
    v_and_b32_dpp v41, v58, v5 row_newbcast:12 row_mask:0xf bank_mask:0xf
    v_and_b32_dpp v42, v58, v6 row_newbcast:12 row_mask:0xf bank_mask:0xf
    v_and_b32_dpp v43, v58, v7 row_newbcast:12 row_mask:0xf bank_mask:0xf
    s_waitcnt vmcnt(4)
    s_nop 0
    v_mfma_f32_16x16x32_bf16 v[24:27], v[40:43], a[60:63], v[24:27]
    v_and_b32_dpp v28, v59, v4 row_newbcast:0 row_mask:0xf bank_mask:0xf
    v_and_b32_dpp v29, v59, v5 row_newbcast:0 row_mask:0xf bank_mask:0xf
    v_and_b32_dpp v30, v59, v6 row_newbcast:0 row_mask:0xf bank_mask:0xf
    v_and_b32_dpp v31, v59, v7 row_newbcast:0 row_mask:0xf bank_mask:0xf
    s_waitcnt vmcnt(3)
    s_nop 0
    v_mfma_f32_16x16x32_bf16 v[24:27], v[28:31], a[64:67], v[24:27]
    v_and_b32_dpp v32, v59, v4 row_newbcast:4 row_mask:0xf bank_mask:0xf
    v_and_b32_dpp v33, v59, v5 row_newbcast:4 row_mask:0xf bank_mask:0xf
    v_and_b32_dpp v34, v59, v6 row_newbcast:4 row_mask:0xf bank_mask:0xf
    v_and_b32_dpp v35, v59, v7 row_newbcast:4 row_mask:0xf bank_mask:0xf
    s_waitcnt vmcnt(2)
    s_nop 0
    v_mfma_f32_16x16x32_bf16 v[24:27], v[32:35], a[68:71], v[24:27]
    v_and_b32_dpp v36, v59, v4 row_newbcast:8 row_mask:0xf bank_mask:0xf
    v_and_b32_dpp v37, v59, v5 row_newbcast:8 row_mask:0xf bank_mask:0xf
    v_and_b32_dpp v38, v59, v6 row_newbcast:8 row_mask:0xf bank_mask:0xf
    v_and_b32_dpp v39, v59, v7 row_newbcast:8 row_mask:0xf bank_mask:0xf
    s_waitcnt vmcnt(1)
    s_nop 0
    v_mfma_f32_16x16x32_bf16 v[24:27], v[36:39], a[72:75], v[24:27]
    v_and_b32_dpp v40, v59, v4 row_newbcast:12 row_mask:0xf bank_mask:0xf
    v_and_b32_dpp v41, v59, v5 row_newbcast:12 row_mask:0xf bank_mask:0xf
    v_and_b32_dpp v42, v59, v6 row_newbcast:12 row_mask:0xf bank_mask:0xf
    v_and_b32_dpp v43, v59, v7 row_newbcast:12 row_mask:0xf bank_mask:0xf
    s_waitcnt vmcnt(0)
    s_nop 0
    v_mfma_f32_16x16x32_bf16 v[24:27], v[40:43], a[76:79], v[24:27]
    s_nop 7
    v_permlane32_swap_b32 v24, v26
    v_permlane32_swap_b32 v25, v27
    s_cmp_eq_u32 s33, 31
    s_cbranch_scc1 L_merge
    v_mov_b32 v26, s28
    v_mov_b32 v48, s32
    v_mov_b32 v27, s35
    v_cndmask_b32 v26, v26, v48, s[38:39]
    global_store_dwordx4 v51, v[24:27], s[14:15] sc0 sc1
L_exit:
    s_endpgm
L_merge:
    v_mov_b32 v80, v24
    v_mov_b32 v81, v25
    v_mov_b32 v82, s28
    v_mov_b32 v83, s32
    s_mov_b32 s31, 0x100000
L_poll:
    global_load_dwordx4 v[84:87], v9, s[14:15] sc0 sc1
    global_load_dwordx4 v[88:91], v10, s[14:15] sc0 sc1
    global_load_dwordx4 v[92:95], v11, s[14:15] sc0 sc1
    global_load_dwordx4 v[96:99], v12, s[14:15] sc0 sc1
    global_load_dwordx4 v[100:103], v13, s[14:15] sc0 sc1
    global_load_dwordx4 v[104:107], v14, s[14:15] sc0 sc1
    global_load_dwordx4 v[108:111], v15, s[14:15] sc0 sc1
    s_sub_u32 s31, s31, 1
    s_waitcnt vmcnt(0)
    s_cbranch_scc1 L_exit
    v_min3_u32 v45, v87, v91, v95
    v_min3_u32 v45, v45, v99, v103
    v_min3_u32 v45, v45, v107, v111
    v_max3_u32 v46, v87, v91, v95
    v_max3_u32 v46, v46, v99, v103
    v_max3_u32 v46, v46, v107, v111
    v_xor_b32 v45, s35, v45
    v_xor_b32 v46, s35, v46
    v_or_b32 v45, v45, v46
    v_cmp_ne_u32 vcc, 0, v45
    s_cbranch_vccnz L_poll
    v_mov_b32_dpp v87, v86 quad_perm:[1,1,3,3] row_mask:0xf bank_mask:0xf
    v_mov_b32_dpp v91, v90 quad_perm:[1,1,3,3] row_mask:0xf bank_mask:0xf
    v_mov_b32_dpp v95, v94 quad_perm:[1,1,3,3] row_mask:0xf bank_mask:0xf
    v_mov_b32_dpp v99, v98 quad_perm:[1,1,3,3] row_mask:0xf bank_mask:0xf
    v_mov_b32_dpp v103, v102 quad_perm:[1,1,3,3] row_mask:0xf bank_mask:0xf
    v_mov_b32_dpp v107, v106 quad_perm:[1,1,3,3] row_mask:0xf bank_mask:0xf
    v_mov_b32_dpp v111, v110 quad_perm:[1,1,3,3] row_mask:0xf bank_mask:0xf
    v_mov_b32_dpp v86, v86 quad_perm:[0,0,2,2] row_mask:0xf bank_mask:0xf
    v_mov_b32_dpp v90, v90 quad_perm:[0,0,2,2] row_mask:0xf bank_mask:0xf
    v_mov_b32_dpp v94, v94 quad_perm:[0,0,2,2] row_mask:0xf bank_mask:0xf
    v_mov_b32_dpp v98, v98 quad_perm:[0,0,2,2] row_mask:0xf bank_mask:0xf
    v_mov_b32_dpp v102, v102 quad_perm:[0,0,2,2] row_mask:0xf bank_mask:0xf
    v_mov_b32_dpp v106, v106 quad_perm:[0,0,2,2] row_mask:0xf bank_mask:0xf
    v_mov_b32_dpp v110, v110 quad_perm:[0,0,2,2] row_mask:0xf bank_mask:0xf
    v_max3_f32 v66, v82, v86, v90
    v_max3_f32 v66, v66, v94, v98
    v_max3_f32 v66, v66, v102, v106
    v_max_f32 v66, v66, v110
    v_sub_f32 v82, v82, v66
    v_sub_f32 v86, v86, v66
    v_sub_f32 v90, v90, v66
    v_sub_f32 v94, v94, v66
    v_sub_f32 v98, v98, v66
    v_sub_f32 v102, v102, v66
    v_sub_f32 v106, v106, v66
    v_sub_f32 v110, v110, v66
    v_exp_f32 v82, v82
    v_exp_f32 v86, v86
    v_exp_f32 v90, v90
    v_exp_f32 v94, v94
    v_exp_f32 v98, v98
    v_exp_f32 v102, v102
    v_exp_f32 v106, v106
    v_exp_f32 v110, v110
    v_mul_f32 v67, v82, v83
    v_fmac_f32 v67, v86, v87
    v_fmac_f32 v67, v90, v91
    v_fmac_f32 v67, v94, v95
    v_fmac_f32 v67, v98, v99
    v_fmac_f32 v67, v102, v103
    v_fmac_f32 v67, v106, v107
    v_fmac_f32 v67, v110, v111
    v_rcp_f32 v67, v67
    v_mul_f32 v64, v82, v80
    v_mul_f32 v65, v82, v81
    v_fmac_f32 v64, v86, v84
    v_fmac_f32 v65, v86, v85
    v_fmac_f32 v64, v90, v88
    v_fmac_f32 v65, v90, v89
    v_fmac_f32 v64, v94, v92
    v_fmac_f32 v65, v94, v93
    v_fmac_f32 v64, v98, v96
    v_fmac_f32 v65, v98, v97
    v_fmac_f32 v64, v102, v100
    v_fmac_f32 v65, v102, v101
    v_fmac_f32 v64, v106, v104
    v_fmac_f32 v65, v106, v105
    v_fmac_f32 v64, v110, v108
    v_fmac_f32 v65, v110, v109
    v_mul_f32 v64, v67, v64
    v_mul_f32 v65, v67, v65
    v_cvt_pk_bf16_f32 v64, v64, v65
    global_store_dword v52, v64, s[10:11]
    s_endpgm
L_tag:
    s_mov_b32 s45, 1
    s_cmp_gt_u32 s27, 160
    s_cbranch_scc1 L_pick
    s_mov_b32 s31, 0x100000
L_tag_test:
    v_readfirstlane_b32 s35, v50
    s_nop 3
    s_cmp_lg_u32 s35, 0
    s_cbranch_scc1 L_tag_known
    global_load_dword v50, v3, s[12:13] sc0 sc1
    s_cmp_gt_u32 s27, 1
    s_cbranch_scc1 L_pick
    s_sub_u32 s31, s31, 1
    s_waitcnt vmcnt(0)
    s_cbranch_scc0 L_tag_test
    s_endpgm
L_tag_known:
    s_mov_b32 s46, 512
    s_cmp_eq_u32 s27, 1
    s_cbranch_scc1 L_tagged
    s_mul_i32 s44, s35, 0x9e3779b1
    s_sub_u32 s44, s44, s27
    s_branch L_pick
L_raise_1:
    s_nop 1
    v_max_f32_dpp v48, v53, v53 row_ror:4 row_mask:0xf bank_mask:0xf
    s_nop 1
    v_max_f32_dpp v48, v48, v48 row_ror:8 row_mask:0xf bank_mask:0xf
    s_nop 1
    v_max_f32_dpp v48, v48, v48 row_bcast:15 row_mask:0xa bank_mask:0xf
    s_nop 1
    v_max_f32_dpp v48, v48, v48 row_bcast:31 row_mask:0xc bank_mask:0xf
    s_nop 1
    v_readlane_b32 s29, v48, 63
    s_nop 1
    v_mov_b32 v48, s29
    v_sub_f32 v48, s28, v48
    v_exp_f32 v48, v48
    s_mov_b32 s28, s29
    v_mul_f32 v44, v48, v44
    v_mul_f32 v24, v48, v24
    v_mul_f32 v25, v48, v25
    v_mul_f32 v26, v48, v26
    v_mul_f32 v27, v48, v27
    s_branch L_keep_1
L_raise_2:
    s_nop 1
    v_max_f32_dpp v48, v53, v53 row_ror:4 row_mask:0xf bank_mask:0xf
    s_nop 1
    v_max_f32_dpp v48, v48, v48 row_ror:8 row_mask:0xf bank_mask:0xf
    s_nop 1
    v_max_f32_dpp v48, v48, v48 row_bcast:15 row_mask:0xa bank_mask:0xf
    s_nop 1
    v_max_f32_dpp v48, v48, v48 row_bcast:31 row_mask:0xc bank_mask:0xf
    s_nop 1
    v_readlane_b32 s29, v48, 63
    s_nop 1
    v_mov_b32 v48, s29
    v_sub_f32 v48, s28, v48
    v_exp_f32 v48, v48
    s_mov_b32 s28, s29
    v_mul_f32 v44, v48, v44
    v_mul_f32 v24, v48, v24
    v_mul_f32 v25, v48, v25
    v_mul_f32 v26, v48, v26
    v_mul_f32 v27, v48, v27
    s_branch L_keep_2
L_raise_3:
    s_nop 1
    v_max_f32_dpp v48, v53, v53 row_ror:4 row_mask:0xf bank_mask:0xf
    s_nop 1
    v_max_f32_dpp v48, v48, v48 row_ror:8 row_mask:0xf bank_mask:0xf
    s_nop 1
    v_max_f32_dpp v48, v48, v48 row_bcast:15 row_mask:0xa bank_mask:0xf
    s_nop 1
    v_max_f32_dpp v48, v48, v48 row_bcast:31 row_mask:0xc bank_mask:0xf
    s_nop 1
    v_readlane_b32 s29, v48, 63
    s_nop 1
    v_mov_b32 v48, s29
    v_sub_f32 v48, s28, v48
    v_exp_f32 v48, v48
    s_mov_b32 s28, s29
    v_mul_f32 v44, v48, v44
    v_mul_f32 v24, v48, v24
    v_mul_f32 v25, v48, v25
    v_mul_f32 v26, v48, v26
    v_mul_f32 v27, v48, v27
    s_branch L_keep_3
L_raise_4:
    s_nop 1
    v_max_f32_dpp v48, v53, v53 row_ror:4 row_mask:0xf bank_mask:0xf
    s_nop 1
    v_max_f32_dpp v48, v48, v48 row_ror:8 row_mask:0xf bank_mask:0xf
    s_nop 1
    v_max_f32_dpp v48, v48, v48 row_bcast:15 row_mask:0xa bank_mask:0xf
    s_nop 1
    v_max_f32_dpp v48, v48, v48 row_bcast:31 row_mask:0xc bank_mask:0xf
    s_nop 1
    v_readlane_b32 s29, v48, 63
    s_nop 1
    v_mov_b32 v48, s29
    v_sub_f32 v48, s28, v48
    v_exp_f32 v48, v48
    s_mov_b32 s28, s29
    v_mul_f32 v44, v48, v44
    v_mul_f32 v24, v48, v24
    v_mul_f32 v25, v48, v25
    v_mul_f32 v26, v48, v26
    v_mul_f32 v27, v48, v27
    s_branch L_keep_4
.section .rodata,"a"
.p2align 6
.amdhsa_kernel standalone__softmax_full_bidir__decode_kernel
  .amdhsa_next_free_vgpr 240
  .amdhsa_next_free_sgpr 52
  .amdhsa_accum_offset 160
  .amdhsa_group_segment_fixed_size 0
  .amdhsa_kernarg_size 48
  .amdhsa_user_sgpr_count 2
  .amdhsa_user_sgpr_kernarg_segment_ptr 1
  .amdhsa_system_sgpr_workgroup_id_x 1
.end_amdhsa_kernel
```
